```python
import torch

def _softmax(x, axis=-1):
    return torch.softmax(x, dim=axis)
def _gelu(x):
    return torch.nn.functional.gelu(x, approximate="tanh")
def _silu(x):
    return torch.nn.functional.silu(x)
def _sigmoid(x):
    return torch.sigmoid(x)
def _layernorm(x, axis=-1, eps=1e-5):
    m = x.mean(dim=axis, keepdim=True)
    v = x.var(dim=axis, keepdim=True, unbiased=False)
    return (x - m) / torch.sqrt(v + eps)
def _scatter_add(tgt, idx, src, axis=0):
    return tgt.clone().index_add_(axis, idx, src)
def _segment_sum(src, seg, n):
    out = torch.zeros((n,) + src.shape[1:], dtype=src.dtype)
    return out.index_add_(0, seg, src)
def _pad(x, pw):
    flat = tuple(v for pair in reversed(pw) for v in pair)
    return torch.nn.functional.pad(x, flat)

kernel_name = 'standalone__swiglu_ffn__sampling'

def setup_inputs():

    _w = (lambda a: (lambda t: t.to(torch.bfloat16) if t.is_floating_point() else t)(torch.as_tensor(a)))
    B, S, D, F = 16, 4, 1024, 3584
    return {
        "x": _w((lambda *s: torch.randn(*s, dtype=torch.bfloat16) * 0.05)(B, S, D)),
        "w_gate": _w((lambda *s: torch.randn(*s, dtype=torch.bfloat16) * 0.05)(D, F)),
        "w_up": _w((lambda *s: torch.randn(*s, dtype=torch.bfloat16) * 0.05)(D, F)),
        "w_down": _w((lambda *s: torch.randn(*s, dtype=torch.bfloat16) * 0.05)(F, D)),
    }

def reference(x, w_gate, w_up, w_down):
    g = _silu(x @ w_gate)
    u = x @ w_up
    return (g * u) @ w_down
```

```asm
; @launch grid=(256,1,1) block=(256,1,1) lds=81920
.amdgcn_target "amdgcn-amd-amdhsa--gfx950"
.text
.globl standalone__swiglu_ffn__sampling_kernel
.p2align 8
.type standalone__swiglu_ffn__sampling_kernel,@function
standalone__swiglu_ffn__sampling_kernel:
    s_lshr_b32 s33, s2, 3
    s_cmp_ge_u32 s33, 32
    s_cbranch_scc1 L_end
    s_load_dwordx2 s[4:5], s[0:1], 0
    s_load_dwordx2 s[8:9], s[0:1], 8
    s_load_dwordx2 s[12:13], s[0:1], 16
    s_load_dwordx2 s[28:29], s[0:1], 48
    s_getpc_b64 s[68:69]
L_pc:
    v_lshlrev_b32 v5, 7, v0
    v_min_u32 v5, L_last-L_pc, v5
    global_load_dword v22, v5, s[68:69]
    v_lshrrev_b32 v2, 6, v0
    v_and_b32 v1, 63, v0
    s_and_b32 s32, s2, 7
    v_readfirstlane_b32 s34, v2
    s_mov_b32 s7, 0x20000
    s_mov_b32 s6, s7
    s_mov_b32 s10, 7340032
    s_mov_b32 s11, s7
    s_mov_b32 s14, s10
    s_mov_b32 s15, s7
    s_mov_b32 s30, 5242880
    s_mov_b32 s31, s7
    s_mov_b32 s71, 5238784
    v_lshrrev_b32 v3, 3, v1
    v_and_b32 v4, 7, v1
    s_lshl_b32 s35, s34, 10
    s_movk_i32 s66, 4096
    s_cmp_lt_u32 s33, 14
    s_cbranch_scc1 L_up
    s_sub_u32 s41, s33, 12
    s_cmp_ge_u32 s41, 18
    s_cselect_b32 s36, 18, 0
    s_sub_u32 s41, s41, s36
    s_movk_i32 s37, 0x90
    s_bitcmp1_b32 s37, s41
    s_cselect_b32 s36, 3, 0
    s_mov_b32 s37, 0x8020
    s_bitcmp1_b32 s37, s41
    s_cselect_b32 s36, 10, s36
    s_xor_b32 s41, s41, s36
    s_cmp_eq_u32 s34, 0
    s_cbranch_scc1 L_pf_w0
    s_waitcnt lgkmcnt(0)
    buffer_load_dword v203, off, s[28:31], s71 sc1
    s_branch L_pf_other
L_pf_w0:
    v_min_u32 v5, 48, v1
    v_mul_u32_u24 v6, 37, v5
    v_lshrrev_b32 v6, 8, v6
    v_mul_u32_u24 v6, 6272, v6
    v_lshl_add_u32 v6, v5, 7, v6
    v_lshlrev_b32 v8, 11, v1
    s_mul_i32 s39, s32, 896
    s_lshr_b32 s36, s41, 1
    s_mul_i32 s36, s36, 50176
    s_add_u32 s39, s39, s36
    s_lshl_b32 s40, s41, 7
    s_cmp_ge_u32 s41, 16
    s_cselect_b32 s40, s6, s40
    s_mov_b32 s37, 17
    s_mul_i32 s38, s41, 65
    s_lshr_b32 s38, s38, 6
    s_sub_i32 s38, s38, 3
    s_max_i32 s38, s38, 0
    s_min_i32 s38, s38, 16
    s_sub_u32 s38, 17, s38
    s_bitcmp1_b32 s41, 0
    s_waitcnt lgkmcnt(0)
    s_cselect_b64 s[8:9], s[12:13], s[8:9]
    buffer_load_dword v203, off, s[28:31], s71 sc1
L_pf_loop:
    s_cmp_lg_u32 s37, s38
    s_cbranch_scc1 L_pf_nox
    buffer_load_dword v22, v8, s[4:7], s40 offen
L_pf_nox:
    buffer_load_dword v22, v6, s[8:11], s39 offen
    s_add_u32 s39, s39, 451584
    s_sub_u32 s37, s37, 1
    s_cmp_lg_u32 s37, 0
    s_cbranch_scc1 L_pf_loop
    s_branch L_pf_rest
L_up:
    v_and_b32 v5, 2, v3
    v_xor_b32 v5, v5, v4
    v_mul_u32_u24 v6, 7168, v3
    v_lshl_add_u32 v6, v5, 4, v6
    v_xor_b32 v7, 64, v6
    v_bfe_u32 v5, v0, 4, 3
    v_xor_b32 v5, v5, v4
    v_lshlrev_b32 v5, 4, v5
    v_lshl_add_u32 v8, v3, 11, v5
    s_mul_i32 s39, s32, 7
    s_lshr_b32 s36, s33, 1
    s_add_u32 s39, s39, s36
    s_lshl_b32 s39, s39, 7
    s_mul_i32 s36, s34, 57344
    s_add_u32 s39, s39, s36
    s_and_b32 s41, s33, 1
    s_lshl_b32 s40, s41, 16
    s_lshl_b32 s36, s34, 14
    s_add_u32 s40, s40, s36
    s_mov_b32 s67, 229376
    s_xor_b32 s37, s41, 0
    s_lshl_b32 s36, s37, 7
    s_add_u32 s36, s36, s40
    s_mul_i32 s37, s37, 458752
    s_mov_b32 m0, s35
    s_add_u32 s37, s37, s39
    s_waitcnt lgkmcnt(0)
    buffer_load_dwordx4 v8, s[4:7], s36 offen lds
    s_add_u32 m0, m0, s66
    s_nop 0
    buffer_load_dwordx4 v6, s[8:11], s37 offen lds
    s_add_u32 m0, m0, s66
    s_add_u32 s38, s37, s67
    buffer_load_dwordx4 v6, s[8:11], s38 offen lds
    s_add_u32 m0, m0, s66
    s_nop 0
    buffer_load_dwordx4 v7, s[12:15], s37 offen lds
    s_add_u32 m0, m0, s66
    s_nop 0
    buffer_load_dwordx4 v7, s[12:15], s38 offen lds
    s_xor_b32 s37, s41, 1
    s_lshl_b32 s36, s37, 7
    s_add_u32 s36, s36, s40
    s_mul_i32 s37, s37, 458752
    s_add_u32 m0, m0, s66
    s_add_u32 s37, s37, s39
    buffer_load_dwordx4 v8, s[4:7], s36 offen lds
    s_add_u32 m0, m0, s66
    s_nop 0
    buffer_load_dwordx4 v6, s[8:11], s37 offen lds
    s_add_u32 m0, m0, s66
    s_add_u32 s38, s37, s67
    buffer_load_dwordx4 v6, s[8:11], s38 offen lds
    s_add_u32 m0, m0, s66
    s_nop 0
    buffer_load_dwordx4 v7, s[12:15], s37 offen lds
    s_add_u32 m0, m0, s66
    s_nop 0
    buffer_load_dwordx4 v7, s[12:15], s38 offen lds
L_hot_end:
    buffer_load_dword v203, off, s[28:31], s71 sc1
    s_load_dwordx2 s[16:17], s[0:1], 24
    s_load_dwordx2 s[20:21], s[0:1], 32
    s_load_dwordx2 s[24:25], s[0:1], 40
    s_mov_b32 s18, s10
    s_mov_b32 s19, s7
    s_mov_b32 s22, s7
    s_mov_b32 s23, s7
    s_movk_i32 s26, 256
    s_mov_b32 s27, s7
    v_bfe_u32 v5, v1, 4, 1
    v_lshlrev_b32 v9, 13, v5
    v_mul_u32_u24 v25, 3584, v5
    v_lshrrev_b32 v5, 5, v1
    v_lshl_add_u32 v9, v5, 10, v9
    v_lshl_add_u32 v25, v5, 6, v25
    v_bfe_u32 v10, v1, 2, 2
    v_lshl_add_u32 v9, v10, 7, v9
    v_and_b32 v10, 3, v3
    v_xor_b32 v10, v10, v2
    v_lshl_add_u32 v9, v10, 5, v9
    v_and_b32 v10, 3, v1
    v_lshl_add_u32 v9, v10, 3, v9
    v_add_u32 v9, s66, v9
    v_add_u32 v10, 40960, v9
    v_bfe_u32 v11, v1, 1, 3
    v_xor_b32 v11, v11, v5
    v_lshlrev_b32 v11, 4, v11
    v_and_b32 v5, 31, v1
    v_lshl_add_u32 v11, v5, 7, v11
    v_xor_b32 v12, 32, v11
    v_xor_b32 v13, 64, v11
    v_xor_b32 v14, 96, v11
    v_and_b32 v5, 15, v1
    v_lshl_add_u32 v25, v5, 2, v25
    v_lshlrev_b32 v24, 2, v25
    v_and_b32 v5, 6, v3
    v_xor_b32 v5, v5, v4
    v_lshlrev_b32 v5, 4, v5
    v_lshl_add_u32 v15, v3, 11, v5
    s_mul_i32 s42, s32, 917504
    s_and_b32 s36, s33, 15
    s_lshl_b32 s36, s36, 7
    s_add_u32 s42, s42, s36
    s_lshl_b32 s37, s34, 14
    s_add_u32 s42, s42, s37
    s_lshr_b32 s38, s33, 4
    s_lshl_b32 s61, s38, 16
    s_add_u32 s61, s61, s36
    s_lshl_b32 s36, s32, 13
    s_add_u32 s61, s61, s36
    s_lshl_b32 s36, s34, 5
    s_add_u32 s61, s61, s36
    s_lshr_b32 s36, s34, 1
    s_lshl_b32 s37, s32, 1
    s_add_u32 s37, s37, s38
    s_lshl_b32 s37, s37, 1
    s_and_b32 s38, s34, 1
    s_add_u32 s37, s37, s38
    s_lshl_b32 s37, s37, 1
    s_add_u32 s37, s37, s36
    s_mul_i32 s37, s37, 7
    s_lshl_b32 s58, s37, 8
    s_add_u32 s58, s58, 524288
    s_lshl_b32 s56, s37, 10
    s_add_u32 s56, s56, 65536
    s_add_u32 s57, s56, s66
    s_lshl_b32 s60, s33, 16
    s_add_u32 s60, s60, 1048576
    s_lshl_b32 s38, s38, 15
    s_add_u32 s59, s60, s38
    s_lshl_b32 s38, s36, 12
    s_add_u32 s59, s59, s38
    s_lshl_b32 s38, s32, 8
    s_add_u32 s59, s59, s38
    s_lshl_b32 s38, s32, 13
    s_add_u32 s60, s60, s38
    s_lshl_b32 s38, s34, 11
    s_add_u32 s60, s60, s38
    s_mov_b32 s52, 0x07060500
    s_add_u32 s53, s52, 1
    s_add_u32 s54, s52, 2
    s_add_u32 s55, s52, 3
    v_lshlrev_b32 v21, 4, v1
    v_lshlrev_b32 v30, 2, v1
    v_mov_b32 v29, v21
    s_add_u32 s38, s38, 57344
    v_add_u32 v23, s38, v21
    v_xor_b32 v31, s66, v23
    v_lshrrev_b32 v2, 5, v1
    v_lshlrev_b32 v2, 11, v2
    v_bfe_u32 v5, v1, 2, 3
    v_lshl_add_u32 v2, v5, 7, v2
    v_and_b32 v5, 3, v1
    v_lshl_add_u32 v2, v5, 3, v2
    s_and_b32 s37, s34, 2
    v_and_b32 v5, 3, v3
    v_xor_b32 v5, s37, v5
    v_lshl_add_u32 v2, v5, 5, v2
    s_mul_i32 s36, s36, 28672
    v_add_u32 v16, s36, v2
    v_xor_b32 v17, 32, v16
    v_xor_b32 v18, 64, v16
    v_xor_b32 v19, 96, v16
    v_lshrrev_b32 v2, 4, v1
    v_and_b32 v5, 15, v1
    v_lshlrev_b32 v26, 13, v2
    v_lshl_add_u32 v26, v5, 4, v26
    v_lshlrev_b32 v27, 11, v2
    v_lshl_add_u32 v27, v5, 1, v27
    s_mov_b32 s73, 262144
    s_lshl_b32 s70, s32, 7
    s_add_u32 s70, s70, 4096
    v_and_b32 v201, 31, v1
    v_lshl_add_u32 v201, v201, 2, s70
    s_lshl_b32 s36, s33, 2
    s_add_u32 s70, s70, s36
    s_lshl_b32 s36, s32, 1
    s_add_u32 s36, s36, s41
    s_and_b32 s37, s33, 14
    s_lshl_b32 s37, s37, 1
    s_add_u32 s37, s37, s34
    s_mul_i32 s38, s36, 56
    s_add_u32 s38, s38, s37
    s_lshl_b32 s64, s38, 9
    s_add_u32 s64, s64, 65536
    s_lshl_b32 s65, s38, 7
    s_add_u32 s65, s65, 524288
    s_mov_b32 s62, 0xffff0000
    s_mov_b32 s63, 0xbfb8aa3b
    s_call_b64 s[68:69], L_stub
    s_add_u32 m0, m0, s66
    s_add_u32 s36, s40, 256
    buffer_load_dwordx4 v8, s[4:7], s36 offen lds
    s_add_u32 m0, m0, s66
    s_add_u32 s37, s39, 917504
    buffer_load_dwordx4 v6, s[8:11], s37 offen lds
    s_add_u32 m0, m0, s66
    s_add_u32 s38, s37, s67
    buffer_load_dwordx4 v6, s[8:11], s38 offen lds
    s_add_u32 m0, m0, s66
    s_nop 0
    buffer_load_dwordx4 v7, s[12:15], s37 offen lds
    s_add_u32 m0, m0, s66
    s_nop 0
    buffer_load_dwordx4 v7, s[12:15], s38 offen lds
    s_waitcnt vmcnt(11)
    s_barrier
    ds_read_b64_tr_b16 v[48:49], v9 offset:0
    ds_read_b64_tr_b16 v[50:51], v9 offset:512
    ds_read_b128 v[52:55], v11 offset:0
    ds_read_b64_tr_b16 v[56:57], v9 offset:2048
    ds_read_b64_tr_b16 v[58:59], v9 offset:2560
    ds_read_b128 v[60:63], v12 offset:0
    ds_read_b64_tr_b16 v[64:65], v9 offset:4096
    ds_read_b64_tr_b16 v[66:67], v9 offset:4608
    ds_read_b128 v[68:71], v13 offset:0
    ds_read_b64_tr_b16 v[72:73], v9 offset:6144
    ds_read_b64_tr_b16 v[74:75], v9 offset:6656
    ds_read_b128 v[76:79], v14 offset:0
    s_add_u32 m0, m0, s66
    s_add_u32 s36, s40, 384
    buffer_load_dwordx4 v8, s[4:7], s36 offen lds
    s_add_u32 m0, m0, s66
    s_add_u32 s37, s39, 1376256
    buffer_load_dwordx4 v6, s[8:11], s37 offen lds
    s_add_u32 m0, m0, s66
    s_add_u32 s38, s37, s67
    buffer_load_dwordx4 v6, s[8:11], s38 offen lds
    s_add_u32 m0, m0, s66
    s_nop 0
    buffer_load_dwordx4 v7, s[12:15], s37 offen lds
    s_add_u32 m0, m0, s66
    s_nop 0
    buffer_load_dwordx4 v7, s[12:15], s38 offen lds
    s_waitcnt vmcnt(10) lgkmcnt(0)
    s_barrier
    ds_read_b64_tr_b16 v[84:85], v9 offset:20480
    ds_read_b64_tr_b16 v[86:87], v9 offset:20992
    ds_read_b128 v[88:91], v11 offset:20480
    ds_read_b64_tr_b16 v[92:93], v9 offset:22528
    ds_read_b64_tr_b16 v[94:95], v9 offset:23040
    ds_read_b128 v[96:99], v12 offset:20480
    v_mfma_f32_32x32x16_bf16 v[32:47], v[48:51], v[52:55], 0
    s_mov_b32 m0, s35
    s_add_u32 s36, s40, 512
    buffer_load_dwordx4 v8, s[4:7], s36 offen lds
    s_add_u32 m0, m0, s66
    s_add_u32 s37, s39, 1835008
    buffer_load_dwordx4 v6, s[8:11], s37 offen lds
    ds_read_b64_tr_b16 v[100:101], v9 offset:24576
    ds_read_b64_tr_b16 v[102:103], v9 offset:25088
    ds_read_b128 v[104:107], v13 offset:20480
    ds_read_b64_tr_b16 v[108:109], v9 offset:26624
    ds_read_b64_tr_b16 v[110:111], v9 offset:27136
    ds_read_b128 v[112:115], v14 offset:20480
    v_mfma_f32_32x32x16_bf16 v[32:47], v[56:59], v[60:63], v[32:47]
    s_add_u32 m0, m0, s66
    s_add_u32 s38, s37, s67
    buffer_load_dwordx4 v6, s[8:11], s38 offen lds
    v_mfma_f32_32x32x16_bf16 v[32:47], v[64:67], v[68:71], v[32:47]
    s_add_u32 m0, m0, s66
    s_nop 0
    buffer_load_dwordx4 v7, s[12:15], s37 offen lds
    v_mfma_f32_32x32x16_bf16 v[32:47], v[72:75], v[76:79], v[32:47]
    s_add_u32 m0, m0, s66
    s_nop 0
    buffer_load_dwordx4 v7, s[12:15], s38 offen lds
    buffer_load_dword v20, off, s[24:27], 0 sc1
    s_waitcnt vmcnt(11) lgkmcnt(0)
    s_barrier
    ds_read_b64_tr_b16 v[48:49], v10 offset:0
    ds_read_b64_tr_b16 v[50:51], v10 offset:512
    ds_read_b128 v[52:55], v11 offset:40960
    ds_read_b64_tr_b16 v[56:57], v10 offset:2048
    ds_read_b64_tr_b16 v[58:59], v10 offset:2560
    ds_read_b128 v[60:63], v12 offset:40960
    v_mfma_f32_32x32x16_bf16 v[32:47], v[84:87], v[88:91], v[32:47]
    s_add_u32 m0, m0, s66
    s_add_u32 s36, s40, 640
    buffer_load_dwordx4 v8, s[4:7], s36 offen lds
    s_add_u32 m0, m0, s66
    s_add_u32 s37, s39, 2293760
    buffer_load_dwordx4 v6, s[8:11], s37 offen lds
    ds_read_b64_tr_b16 v[64:65], v10 offset:4096
    ds_read_b64_tr_b16 v[66:67], v10 offset:4608
    ds_read_b128 v[68:71], v13 offset:40960
    ds_read_b64_tr_b16 v[72:73], v10 offset:6144
    ds_read_b64_tr_b16 v[74:75], v10 offset:6656
    ds_read_b128 v[76:79], v14 offset:40960
    v_mfma_f32_32x32x16_bf16 v[32:47], v[92:95], v[96:99], v[32:47]
    s_add_u32 m0, m0, s66
    s_add_u32 s38, s37, s67
    buffer_load_dwordx4 v6, s[8:11], s38 offen lds
    v_mfma_f32_32x32x16_bf16 v[32:47], v[100:103], v[104:107], v[32:47]
    s_add_u32 m0, m0, s66
    s_nop 0
    buffer_load_dwordx4 v7, s[12:15], s37 offen lds
    v_mfma_f32_32x32x16_bf16 v[32:47], v[108:111], v[112:115], v[32:47]
    s_add_u32 m0, m0, s66
    s_nop 0
    buffer_load_dwordx4 v7, s[12:15], s38 offen lds
    s_getreg_b32 s68, hwreg(HW_REG_XCC_ID, 0, 4)
    s_lshl_b32 s68, s68, 24
    s_add_u32 s68, s68, 0x5a
    v_add_u32 v202, s68, v203
    s_mov_b64 exec, 1
    buffer_store_dword v202, off, s[28:31], s70
    s_mov_b64 exec, -1
    s_waitcnt vmcnt(12) lgkmcnt(0)
    s_barrier
    ds_read_b64_tr_b16 v[84:85], v10 offset:20480
    ds_read_b64_tr_b16 v[86:87], v10 offset:20992
    ds_read_b128 v[88:91], v11 offset:61440
    ds_read_b64_tr_b16 v[92:93], v10 offset:22528
    ds_read_b64_tr_b16 v[94:95], v10 offset:23040
    ds_read_b128 v[96:99], v12 offset:61440
    v_mfma_f32_32x32x16_bf16 v[32:47], v[48:51], v[52:55], v[32:47]
    s_add_u32 m0, m0, s66
    s_add_u32 s36, s40, 768
    buffer_load_dwordx4 v8, s[4:7], s36 offen lds
    s_add_u32 m0, m0, s66
    s_add_u32 s37, s39, 2752512
    buffer_load_dwordx4 v6, s[8:11], s37 offen lds
    ds_read_b64_tr_b16 v[100:101], v10 offset:24576
    ds_read_b64_tr_b16 v[102:103], v10 offset:25088
    ds_read_b128 v[104:107], v13 offset:61440
    ds_read_b64_tr_b16 v[108:109], v10 offset:26624
    ds_read_b64_tr_b16 v[110:111], v10 offset:27136
    ds_read_b128 v[112:115], v14 offset:61440
    v_mfma_f32_32x32x16_bf16 v[32:47], v[56:59], v[60:63], v[32:47]
    s_add_u32 m0, m0, s66
    s_add_u32 s38, s37, s67
    buffer_load_dwordx4 v6, s[8:11], s38 offen lds
    v_mfma_f32_32x32x16_bf16 v[32:47], v[64:67], v[68:71], v[32:47]
    s_add_u32 m0, m0, s66
    s_nop 0
    buffer_load_dwordx4 v7, s[12:15], s37 offen lds
    v_mfma_f32_32x32x16_bf16 v[32:47], v[72:75], v[76:79], v[32:47]
    s_add_u32 m0, m0, s66
    s_nop 0
    buffer_load_dwordx4 v7, s[12:15], s38 offen lds
    s_waitcnt vmcnt(11) lgkmcnt(0)
    s_barrier
    ds_read_b64_tr_b16 v[48:49], v9 offset:0
    ds_read_b64_tr_b16 v[50:51], v9 offset:512
    ds_read_b128 v[52:55], v11 offset:0
    ds_read_b64_tr_b16 v[56:57], v9 offset:2048
    ds_read_b64_tr_b16 v[58:59], v9 offset:2560
    ds_read_b128 v[60:63], v12 offset:0
    v_mfma_f32_32x32x16_bf16 v[32:47], v[84:87], v[88:91], v[32:47]
    s_add_u32 m0, m0, s66
    s_add_u32 s36, s40, 896
    buffer_load_dwordx4 v8, s[4:7], s36 offen lds
    s_add_u32 m0, m0, s66
    s_add_u32 s37, s39, 3211264
    buffer_load_dwordx4 v6, s[8:11], s37 offen lds
    ds_read_b64_tr_b16 v[64:65], v9 offset:4096
    ds_read_b64_tr_b16 v[66:67], v9 offset:4608
    ds_read_b128 v[68:71], v13 offset:0
    ds_read_b64_tr_b16 v[72:73], v9 offset:6144
    ds_read_b64_tr_b16 v[74:75], v9 offset:6656
    ds_read_b128 v[76:79], v14 offset:0
    v_mfma_f32_32x32x16_bf16 v[32:47], v[92:95], v[96:99], v[32:47]
    s_add_u32 m0, m0, s66
    s_add_u32 s38, s37, s67
    buffer_load_dwordx4 v6, s[8:11], s38 offen lds
    v_mfma_f32_32x32x16_bf16 v[32:47], v[100:103], v[104:107], v[32:47]
    s_add_u32 m0, m0, s66
    s_nop 0
    buffer_load_dwordx4 v7, s[12:15], s37 offen lds
    v_mfma_f32_32x32x16_bf16 v[32:47], v[108:111], v[112:115], v[32:47]
    s_add_u32 m0, m0, s66
    s_nop 0
    buffer_load_dwordx4 v7, s[12:15], s38 offen lds
    s_waitcnt vmcnt(10) lgkmcnt(0)
    s_barrier
    ds_read_b64_tr_b16 v[84:85], v9 offset:20480
    ds_read_b64_tr_b16 v[86:87], v9 offset:20992
    ds_read_b128 v[88:91], v11 offset:20480
    ds_read_b64_tr_b16 v[92:93], v9 offset:22528
    ds_read_b64_tr_b16 v[94:95], v9 offset:23040
    ds_read_b128 v[96:99], v12 offset:20480
    v_mfma_f32_32x32x16_bf16 v[32:47], v[48:51], v[52:55], v[32:47]
    s_mov_b32 m0, s35
    s_add_u32 s36, s40, 1024
    buffer_load_dwordx4 v8, s[4:7], s36 offen lds
    s_add_u32 m0, m0, s66
    s_add_u32 s37, s39, 3670016
    buffer_load_dwordx4 v6, s[8:11], s37 offen lds
    ds_read_b64_tr_b16 v[100:101], v9 offset:24576
    ds_read_b64_tr_b16 v[102:103], v9 offset:25088
    ds_read_b128 v[104:107], v13 offset:20480
    ds_read_b64_tr_b16 v[108:109], v9 offset:26624
    ds_read_b64_tr_b16 v[110:111], v9 offset:27136
    ds_read_b128 v[112:115], v14 offset:20480
    v_mfma_f32_32x32x16_bf16 v[32:47], v[56:59], v[60:63], v[32:47]
    s_add_u32 m0, m0, s66
    s_add_u32 s38, s37, s67
    buffer_load_dwordx4 v6, s[8:11], s38 offen lds
    v_mfma_f32_32x32x16_bf16 v[32:47], v[64:67], v[68:71], v[32:47]
    s_add_u32 m0, m0, s66
    s_nop 0
    buffer_load_dwordx4 v7, s[12:15], s37 offen lds
    v_mfma_f32_32x32x16_bf16 v[32:47], v[72:75], v[76:79], v[32:47]
    s_add_u32 m0, m0, s66
    s_nop 0
    buffer_load_dwordx4 v7, s[12:15], s38 offen lds
    v_readfirstlane_b32 s74, v203
    v_readfirstlane_b32 s75, v20
    s_nop 0
    s_add_u32 s74, s74, 0x01010101
    s_cmp_eq_u32 s74, 0
    s_cselect_b32 s74, 0x02020202, s74
    s_cmp_eq_u32 s75, 0
    s_cselect_b32 s46, s74, s75
    v_mov_b32 v20, s46
    s_bfe_u32 s48, s46, 524288
    s_bfe_u32 s49, s46, 524296
    s_bfe_u32 s50, s46, 524304
    s_bfe_u32 s51, s46, 524312
    s_cmp_eq_u32 s74, s46
    s_cbranch_scc1 L_mk_up
    s_mov_b64 exec, 1
    buffer_store_dword v20, off, s[28:31], s70
    s_mov_b64 exec, -1
L_mk_up:
    s_waitcnt vmcnt(10) lgkmcnt(0)
    s_barrier
    ds_read_b64_tr_b16 v[48:49], v10 offset:0
    ds_read_b64_tr_b16 v[50:51], v10 offset:512
    ds_read_b128 v[52:55], v11 offset:40960
    ds_read_b64_tr_b16 v[56:57], v10 offset:2048
    ds_read_b64_tr_b16 v[58:59], v10 offset:2560
    ds_read_b128 v[60:63], v12 offset:40960
    v_mfma_f32_32x32x16_bf16 v[32:47], v[84:87], v[88:91], v[32:47]
    s_add_u32 m0, m0, s66
    s_add_u32 s36, s40, 1152
    buffer_load_dwordx4 v8, s[4:7], s36 offen lds
    s_add_u32 m0, m0, s66
    s_add_u32 s37, s39, 4128768
    buffer_load_dwordx4 v6, s[8:11], s37 offen lds
    ds_read_b64_tr_b16 v[64:65], v10 offset:4096
    ds_read_b64_tr_b16 v[66:67], v10 offset:4608
    ds_read_b128 v[68:71], v13 offset:40960
    ds_read_b64_tr_b16 v[72:73], v10 offset:6144
    ds_read_b64_tr_b16 v[74:75], v10 offset:6656
    ds_read_b128 v[76:79], v14 offset:40960
    v_mfma_f32_32x32x16_bf16 v[32:47], v[92:95], v[96:99], v[32:47]
    s_add_u32 m0, m0, s66
    s_add_u32 s38, s37, s67
    buffer_load_dwordx4 v6, s[8:11], s38 offen lds
    v_mfma_f32_32x32x16_bf16 v[32:47], v[100:103], v[104:107], v[32:47]
    s_add_u32 m0, m0, s66
    s_nop 0
    buffer_load_dwordx4 v7, s[12:15], s37 offen lds
    v_mfma_f32_32x32x16_bf16 v[32:47], v[108:111], v[112:115], v[32:47]
    s_add_u32 m0, m0, s66
    s_nop 0
    buffer_load_dwordx4 v7, s[12:15], s38 offen lds
    s_waitcnt vmcnt(10) lgkmcnt(0)
    s_barrier
    ds_read_b64_tr_b16 v[84:85], v10 offset:20480
    ds_read_b64_tr_b16 v[86:87], v10 offset:20992
    ds_read_b128 v[88:91], v11 offset:61440
    ds_read_b64_tr_b16 v[92:93], v10 offset:22528
    ds_read_b64_tr_b16 v[94:95], v10 offset:23040
    ds_read_b128 v[96:99], v12 offset:61440
    v_mfma_f32_32x32x16_bf16 v[32:47], v[48:51], v[52:55], v[32:47]
    s_add_u32 m0, m0, s66
    s_add_u32 s36, s40, 1280
    buffer_load_dwordx4 v8, s[4:7], s36 offen lds
    s_add_u32 m0, m0, s66
    s_add_u32 s37, s39, 4587520
    buffer_load_dwordx4 v6, s[8:11], s37 offen lds
    ds_read_b64_tr_b16 v[100:101], v10 offset:24576
    ds_read_b64_tr_b16 v[102:103], v10 offset:25088
    ds_read_b128 v[104:107], v13 offset:61440
    ds_read_b64_tr_b16 v[108:109], v10 offset:26624
    ds_read_b64_tr_b16 v[110:111], v10 offset:27136
    ds_read_b128 v[112:115], v14 offset:61440
    v_mfma_f32_32x32x16_bf16 v[32:47], v[56:59], v[60:63], v[32:47]
    s_add_u32 m0, m0, s66
    s_add_u32 s38, s37, s67
    buffer_load_dwordx4 v6, s[8:11], s38 offen lds
    v_mfma_f32_32x32x16_bf16 v[32:47], v[64:67], v[68:71], v[32:47]
    s_add_u32 m0, m0, s66
    s_nop 0
    buffer_load_dwordx4 v7, s[12:15], s37 offen lds
    v_mfma_f32_32x32x16_bf16 v[32:47], v[72:75], v[76:79], v[32:47]
    s_add_u32 m0, m0, s66
    s_nop 0
    buffer_load_dwordx4 v7, s[12:15], s38 offen lds
    s_waitcnt vmcnt(10) lgkmcnt(0)
    s_barrier
    ds_read_b64_tr_b16 v[48:49], v9 offset:0
    ds_read_b64_tr_b16 v[50:51], v9 offset:512
    ds_read_b128 v[52:55], v11 offset:0
    ds_read_b64_tr_b16 v[56:57], v9 offset:2048
    ds_read_b64_tr_b16 v[58:59], v9 offset:2560
    ds_read_b128 v[60:63], v12 offset:0
    v_mfma_f32_32x32x16_bf16 v[32:47], v[84:87], v[88:91], v[32:47]
    s_add_u32 m0, m0, s66
    s_add_u32 s36, s40, 1408
    buffer_load_dwordx4 v8, s[4:7], s36 offen lds
    s_add_u32 m0, m0, s66
    s_add_u32 s37, s39, 5046272
    buffer_load_dwordx4 v6, s[8:11], s37 offen lds
    ds_read_b64_tr_b16 v[64:65], v9 offset:4096
    ds_read_b64_tr_b16 v[66:67], v9 offset:4608
    ds_read_b128 v[68:71], v13 offset:0
    ds_read_b64_tr_b16 v[72:73], v9 offset:6144
    ds_read_b64_tr_b16 v[74:75], v9 offset:6656
    ds_read_b128 v[76:79], v14 offset:0
    v_mfma_f32_32x32x16_bf16 v[32:47], v[92:95], v[96:99], v[32:47]
    s_add_u32 m0, m0, s66
    s_add_u32 s38, s37, s67
    buffer_load_dwordx4 v6, s[8:11], s38 offen lds
    v_mfma_f32_32x32x16_bf16 v[32:47], v[100:103], v[104:107], v[32:47]
    s_add_u32 m0, m0, s66
    s_nop 0
    buffer_load_dwordx4 v7, s[12:15], s37 offen lds
    v_mfma_f32_32x32x16_bf16 v[32:47], v[108:111], v[112:115], v[32:47]
    s_add_u32 m0, m0, s66
    s_nop 0
    buffer_load_dwordx4 v7, s[12:15], s38 offen lds
    s_waitcnt vmcnt(10) lgkmcnt(0)
    s_barrier
    ds_read_b64_tr_b16 v[84:85], v9 offset:20480
    ds_read_b64_tr_b16 v[86:87], v9 offset:20992
    ds_read_b128 v[88:91], v11 offset:20480
    ds_read_b64_tr_b16 v[92:93], v9 offset:22528
    ds_read_b64_tr_b16 v[94:95], v9 offset:23040
    ds_read_b128 v[96:99], v12 offset:20480
    v_mfma_f32_32x32x16_bf16 v[32:47], v[48:51], v[52:55], v[32:47]
    s_mov_b32 m0, s35
    s_add_u32 s36, s40, 1536
    buffer_load_dwordx4 v8, s[4:7], s36 offen lds
    s_add_u32 m0, m0, s66
    s_add_u32 s37, s39, 5505024
    buffer_load_dwordx4 v6, s[8:11], s37 offen lds
    ds_read_b64_tr_b16 v[100:101], v9 offset:24576
    ds_read_b64_tr_b16 v[102:103], v9 offset:25088
    ds_read_b128 v[104:107], v13 offset:20480
    ds_read_b64_tr_b16 v[108:109], v9 offset:26624
    ds_read_b64_tr_b16 v[110:111], v9 offset:27136
    ds_read_b128 v[112:115], v14 offset:20480
    v_mfma_f32_32x32x16_bf16 v[32:47], v[56:59], v[60:63], v[32:47]
    s_add_u32 m0, m0, s66
    s_add_u32 s38, s37, s67
    buffer_load_dwordx4 v6, s[8:11], s38 offen lds
    v_mfma_f32_32x32x16_bf16 v[32:47], v[64:67], v[68:71], v[32:47]
    s_add_u32 m0, m0, s66
    s_nop 0
    buffer_load_dwordx4 v7, s[12:15], s37 offen lds
    v_mfma_f32_32x32x16_bf16 v[32:47], v[72:75], v[76:79], v[32:47]
    s_add_u32 m0, m0, s66
    s_nop 0
    buffer_load_dwordx4 v7, s[12:15], s38 offen lds
    s_waitcnt vmcnt(10) lgkmcnt(0)
    s_barrier
    ds_read_b64_tr_b16 v[48:49], v10 offset:0
    ds_read_b64_tr_b16 v[50:51], v10 offset:512
    ds_read_b128 v[52:55], v11 offset:40960
    ds_read_b64_tr_b16 v[56:57], v10 offset:2048
    ds_read_b64_tr_b16 v[58:59], v10 offset:2560
    ds_read_b128 v[60:63], v12 offset:40960
    v_mfma_f32_32x32x16_bf16 v[32:47], v[84:87], v[88:91], v[32:47]
    s_add_u32 m0, m0, s66
    s_add_u32 s36, s40, 1664
    buffer_load_dwordx4 v8, s[4:7], s36 offen lds
    s_add_u32 m0, m0, s66
    s_add_u32 s37, s39, 5963776
    buffer_load_dwordx4 v6, s[8:11], s37 offen lds
    ds_read_b64_tr_b16 v[64:65], v10 offset:4096
    ds_read_b64_tr_b16 v[66:67], v10 offset:4608
    ds_read_b128 v[68:71], v13 offset:40960
    ds_read_b64_tr_b16 v[72:73], v10 offset:6144
    ds_read_b64_tr_b16 v[74:75], v10 offset:6656
    ds_read_b128 v[76:79], v14 offset:40960
    v_mfma_f32_32x32x16_bf16 v[32:47], v[92:95], v[96:99], v[32:47]
    s_add_u32 m0, m0, s66
    s_add_u32 s38, s37, s67
    buffer_load_dwordx4 v6, s[8:11], s38 offen lds
    v_mfma_f32_32x32x16_bf16 v[32:47], v[100:103], v[104:107], v[32:47]
    s_add_u32 m0, m0, s66
    s_nop 0
    buffer_load_dwordx4 v7, s[12:15], s37 offen lds
    v_mfma_f32_32x32x16_bf16 v[32:47], v[108:111], v[112:115], v[32:47]
    s_add_u32 m0, m0, s66
    s_nop 0
    buffer_load_dwordx4 v7, s[12:15], s38 offen lds
    s_waitcnt vmcnt(10) lgkmcnt(0)
    s_barrier
    ds_read_b64_tr_b16 v[84:85], v10 offset:20480
    ds_read_b64_tr_b16 v[86:87], v10 offset:20992
    ds_read_b128 v[88:91], v11 offset:61440
    ds_read_b64_tr_b16 v[92:93], v10 offset:22528
    ds_read_b64_tr_b16 v[94:95], v10 offset:23040
    ds_read_b128 v[96:99], v12 offset:61440
    v_mfma_f32_32x32x16_bf16 v[32:47], v[48:51], v[52:55], v[32:47]
    s_add_u32 m0, m0, s66
    s_add_u32 s36, s40, 1792
    buffer_load_dwordx4 v8, s[4:7], s36 offen lds
    s_add_u32 m0, m0, s66
    s_add_u32 s37, s39, 6422528
    buffer_load_dwordx4 v6, s[8:11], s37 offen lds
    ds_read_b64_tr_b16 v[100:101], v10 offset:24576
    ds_read_b64_tr_b16 v[102:103], v10 offset:25088
    ds_read_b128 v[104:107], v13 offset:61440
    ds_read_b64_tr_b16 v[108:109], v10 offset:26624
    ds_read_b64_tr_b16 v[110:111], v10 offset:27136
    ds_read_b128 v[112:115], v14 offset:61440
    v_mfma_f32_32x32x16_bf16 v[32:47], v[56:59], v[60:63], v[32:47]
    s_add_u32 m0, m0, s66
    s_add_u32 s38, s37, s67
    buffer_load_dwordx4 v6, s[8:11], s38 offen lds
    v_mfma_f32_32x32x16_bf16 v[32:47], v[64:67], v[68:71], v[32:47]
    s_add_u32 m0, m0, s66
    s_nop 0
    buffer_load_dwordx4 v7, s[12:15], s37 offen lds
    v_mfma_f32_32x32x16_bf16 v[32:47], v[72:75], v[76:79], v[32:47]
    s_add_u32 m0, m0, s66
    s_nop 0
    buffer_load_dwordx4 v7, s[12:15], s38 offen lds
    s_waitcnt vmcnt(10) lgkmcnt(0)
    s_barrier
    ds_read_b64_tr_b16 v[48:49], v9 offset:0
    ds_read_b64_tr_b16 v[50:51], v9 offset:512
    ds_read_b128 v[52:55], v11 offset:0
    ds_read_b64_tr_b16 v[56:57], v9 offset:2048
    ds_read_b64_tr_b16 v[58:59], v9 offset:2560
    ds_read_b128 v[60:63], v12 offset:0
    v_mfma_f32_32x32x16_bf16 v[32:47], v[84:87], v[88:91], v[32:47]
    s_add_u32 m0, m0, s66
    s_add_u32 s36, s40, 1920
    buffer_load_dwordx4 v8, s[4:7], s36 offen lds
    s_add_u32 m0, m0, s66
    s_add_u32 s37, s39, 6881280
    buffer_load_dwordx4 v6, s[8:11], s37 offen lds
    ds_read_b64_tr_b16 v[64:65], v9 offset:4096
    ds_read_b64_tr_b16 v[66:67], v9 offset:4608
    ds_read_b128 v[68:71], v13 offset:0
    ds_read_b64_tr_b16 v[72:73], v9 offset:6144
    ds_read_b64_tr_b16 v[74:75], v9 offset:6656
    ds_read_b128 v[76:79], v14 offset:0
    v_mfma_f32_32x32x16_bf16 v[32:47], v[92:95], v[96:99], v[32:47]
    s_add_u32 m0, m0, s66
    s_add_u32 s38, s37, s67
    buffer_load_dwordx4 v6, s[8:11], s38 offen lds
    v_mfma_f32_32x32x16_bf16 v[32:47], v[100:103], v[104:107], v[32:47]
    s_add_u32 m0, m0, s66
    s_nop 0
    buffer_load_dwordx4 v7, s[12:15], s37 offen lds
    v_mfma_f32_32x32x16_bf16 v[32:47], v[108:111], v[112:115], v[32:47]
    s_add_u32 m0, m0, s66
    s_nop 0
    buffer_load_dwordx4 v7, s[12:15], s38 offen lds
    s_waitcnt vmcnt(10) lgkmcnt(0)
    s_barrier
    ds_read_b64_tr_b16 v[84:85], v9 offset:20480
    ds_read_b64_tr_b16 v[86:87], v9 offset:20992
    ds_read_b128 v[88:91], v11 offset:20480
    ds_read_b64_tr_b16 v[92:93], v9 offset:22528
    ds_read_b64_tr_b16 v[94:95], v9 offset:23040
    ds_read_b128 v[96:99], v12 offset:20480
    v_mfma_f32_32x32x16_bf16 v[32:47], v[48:51], v[52:55], v[32:47]
    s_mov_b32 m0, s35
    s_add_u32 s36, s42, 0
    buffer_load_dwordx4 v15, s[16:19], s36 offen lds
    s_add_u32 m0, m0, s66
    s_add_u32 s36, s42, 65536
    buffer_load_dwordx4 v15, s[16:19], s36 offen lds
    ds_read_b64_tr_b16 v[100:101], v9 offset:24576
    ds_read_b64_tr_b16 v[102:103], v9 offset:25088
    ds_read_b128 v[104:107], v13 offset:20480
    ds_read_b64_tr_b16 v[108:109], v9 offset:26624
    ds_read_b64_tr_b16 v[110:111], v9 offset:27136
    ds_read_b128 v[112:115], v14 offset:20480
    v_mfma_f32_32x32x16_bf16 v[32:47], v[56:59], v[60:63], v[32:47]
    s_add_u32 m0, m0, s66
    s_add_u32 s36, s42, 131072
    buffer_load_dwordx4 v15, s[16:19], s36 offen lds
    v_mfma_f32_32x32x16_bf16 v[32:47], v[64:67], v[68:71], v[32:47]
    s_add_u32 m0, m0, s66
    s_add_u32 s36, s42, 196608
    buffer_load_dwordx4 v15, s[16:19], s36 offen lds
    v_mfma_f32_32x32x16_bf16 v[32:47], v[72:75], v[76:79], v[32:47]
    s_add_u32 m0, m0, s66
    s_add_u32 s36, s42, 262144
    buffer_load_dwordx4 v15, s[16:19], s36 offen lds
    s_waitcnt vmcnt(10) lgkmcnt(0)
    s_barrier
    ds_read_b64_tr_b16 v[48:49], v10 offset:0
    ds_read_b64_tr_b16 v[50:51], v10 offset:512
    ds_read_b128 v[52:55], v11 offset:40960
    ds_read_b64_tr_b16 v[56:57], v10 offset:2048
    ds_read_b64_tr_b16 v[58:59], v10 offset:2560
    ds_read_b128 v[60:63], v12 offset:40960
    v_mfma_f32_32x32x16_bf16 v[32:47], v[84:87], v[88:91], v[32:47]
    ds_read_b64_tr_b16 v[64:65], v10 offset:4096
    ds_read_b64_tr_b16 v[66:67], v10 offset:4608
    ds_read_b128 v[68:71], v13 offset:40960
    ds_read_b64_tr_b16 v[72:73], v10 offset:6144
    ds_read_b64_tr_b16 v[74:75], v10 offset:6656
    ds_read_b128 v[76:79], v14 offset:40960
    v_mfma_f32_32x32x16_bf16 v[32:47], v[92:95], v[96:99], v[32:47]
    v_mfma_f32_32x32x16_bf16 v[32:47], v[100:103], v[104:107], v[32:47]
    v_mfma_f32_32x32x16_bf16 v[32:47], v[108:111], v[112:115], v[32:47]
    s_add_u32 m0, m0, s66
    s_add_u32 s36, s42, 327680
    buffer_load_dwordx4 v15, s[16:19], s36 offen lds
    s_add_u32 m0, m0, s66
    s_add_u32 s36, s42, 393216
    buffer_load_dwordx4 v15, s[16:19], s36 offen lds
    s_waitcnt lgkmcnt(0)
    v_mfma_f32_32x32x16_bf16 v[32:47], v[48:51], v[52:55], v[32:47]
    v_mfma_f32_32x32x16_bf16 v[32:47], v[56:59], v[60:63], v[32:47]
    v_mfma_f32_32x32x16_bf16 v[32:47], v[64:67], v[68:71], v[32:47]
    v_mfma_f32_32x32x16_bf16 v[32:47], v[72:75], v[76:79], v[32:47]
    s_waitcnt vmcnt(7)
    s_barrier
    ds_read_b64_tr_b16 v[84:85], v10 offset:20480
    ds_read_b64_tr_b16 v[86:87], v10 offset:20992
    ds_read_b128 v[88:91], v11 offset:61440
    ds_read_b64_tr_b16 v[92:93], v10 offset:22528
    ds_read_b64_tr_b16 v[94:95], v10 offset:23040
    ds_read_b128 v[96:99], v12 offset:61440
    ds_read_b64_tr_b16 v[100:101], v10 offset:24576
    ds_read_b64_tr_b16 v[102:103], v10 offset:25088
    ds_read_b128 v[104:107], v13 offset:61440
    ds_read_b64_tr_b16 v[108:109], v10 offset:26624
    ds_read_b64_tr_b16 v[110:111], v10 offset:27136
    ds_read_b128 v[112:115], v14 offset:61440
    s_waitcnt lgkmcnt(9)
    v_mfma_f32_32x32x16_bf16 v[32:47], v[84:87], v[88:91], v[32:47]
    s_waitcnt lgkmcnt(6)
    v_mfma_f32_32x32x16_bf16 v[32:47], v[92:95], v[96:99], v[32:47]
    s_waitcnt lgkmcnt(3)
    v_mfma_f32_32x32x16_bf16 v[32:47], v[100:103], v[104:107], v[32:47]
    s_waitcnt lgkmcnt(0)
    v_mfma_f32_32x32x16_bf16 v[32:47], v[108:111], v[112:115], v[32:47]
    s_nop 11
    v_cvt_pk_bf16_f32 v32, 0, v32
    v_cvt_pk_bf16_f32 v33, 0, v33
    v_cvt_pk_bf16_f32 v34, 0, v34
    v_cvt_pk_bf16_f32 v35, 0, v35
    v_cvt_pk_bf16_f32 v36, 0, v36
    v_cvt_pk_bf16_f32 v37, 0, v37
    v_cvt_pk_bf16_f32 v38, 0, v38
    v_cvt_pk_bf16_f32 v39, 0, v39
    v_pk_mul_f32 v[56:57], v[32:33], s[62:63] op_sel:[0,1] op_sel_hi:[1,1]
    v_pk_mul_f32 v[58:59], v[34:35], s[62:63] op_sel:[0,1] op_sel_hi:[1,1]
    v_pk_mul_f32 v[60:61], v[36:37], s[62:63] op_sel:[0,1] op_sel_hi:[1,1]
    v_pk_mul_f32 v[62:63], v[38:39], s[62:63] op_sel:[0,1] op_sel_hi:[1,1]
    v_exp_f32 v56, v56
    v_exp_f32 v57, v57
    v_exp_f32 v58, v58
    v_exp_f32 v59, v59
    v_exp_f32 v60, v60
    v_cvt_pk_bf16_f32 v40, 0, v40
    v_exp_f32 v61, v61
    v_cvt_pk_bf16_f32 v41, 0, v41
    v_exp_f32 v62, v62
    v_cvt_pk_bf16_f32 v42, 0, v42
    v_exp_f32 v63, v63
    v_cvt_pk_bf16_f32 v43, 0, v43
    v_pk_add_f32 v[56:57], v[56:57], 1.0 op_sel_hi:[1,0]
    v_pk_add_f32 v[58:59], v[58:59], 1.0 op_sel_hi:[1,0]
    v_pk_add_f32 v[60:61], v[60:61], 1.0 op_sel_hi:[1,0]
    v_pk_add_f32 v[62:63], v[62:63], 1.0 op_sel_hi:[1,0]
    v_rcp_f32 v56, v56
    v_rcp_f32 v57, v57
    v_rcp_f32 v58, v58
    v_rcp_f32 v59, v59
    v_rcp_f32 v60, v60
    v_cvt_pk_bf16_f32 v44, 0, v44
    v_rcp_f32 v61, v61
    v_cvt_pk_bf16_f32 v45, 0, v45
    v_rcp_f32 v62, v62
    v_cvt_pk_bf16_f32 v46, 0, v46
    v_rcp_f32 v63, v63
    v_cvt_pk_bf16_f32 v47, 0, v47
    v_pk_mul_f32 v[32:33], v[32:33], v[56:57]
    v_pk_mul_f32 v[34:35], v[34:35], v[58:59]
    v_pk_mul_f32 v[36:37], v[36:37], v[60:61]
    v_pk_mul_f32 v[38:39], v[38:39], v[62:63]
    v_cvt_pk_bf16_f32 v32, 0, v32
    v_cvt_pk_bf16_f32 v33, 0, v33
    v_cvt_pk_bf16_f32 v34, 0, v34
    v_cvt_pk_bf16_f32 v35, 0, v35
    v_cvt_pk_bf16_f32 v36, 0, v36
    v_cvt_pk_bf16_f32 v37, 0, v37
    v_cvt_pk_bf16_f32 v38, 0, v38
    v_cvt_pk_bf16_f32 v39, 0, v39
    v_pk_mul_f32 v[32:33], v[32:33], v[40:41]
    v_pk_mul_f32 v[34:35], v[34:35], v[42:43]
    v_pk_mul_f32 v[36:37], v[36:37], v[44:45]
    v_pk_mul_f32 v[38:39], v[38:39], v[46:47]
    v_cvt_pk_bf16_f32 v196, v32, v33
    v_cvt_pk_bf16_f32 v197, v34, v35
    v_cvt_pk_bf16_f32 v198, v36, v37
    v_cvt_pk_bf16_f32 v199, v38, v39
    buffer_store_dwordx4 v[196:199], v24, s[28:31], s64 offen
    v_add3_u32 v200, v196, v197, v198
    v_lshl_add_u32 v200, v199, 1, v200
    v_xor_b32 v200, s46, v200
    buffer_store_dword v200, v25, s[28:31], s65 offen
    s_add_u32 m0, m0, s66
    s_add_u32 s36, s42, 458752
    buffer_load_dwordx4 v15, s[16:19], s36 offen lds
    s_add_u32 m0, m0, s66
    s_add_u32 s36, s42, 524288
    buffer_load_dwordx4 v15, s[16:19], s36 offen lds
    s_add_u32 m0, m0, s66
    s_add_u32 s36, s42, 589824
    buffer_load_dwordx4 v15, s[16:19], s36 offen lds
    s_add_u32 m0, m0, s66
    s_add_u32 s36, s42, 655360
    buffer_load_dwordx4 v15, s[16:19], s36 offen lds
    s_add_u32 m0, m0, s66
    s_add_u32 s36, s42, 720896
    buffer_load_dwordx4 v15, s[16:19], s36 offen lds
    s_add_u32 m0, m0, s66
    s_add_u32 s36, s42, 786432
    buffer_load_dwordx4 v15, s[16:19], s36 offen lds
    s_add_u32 m0, m0, s66
    s_add_u32 s36, s42, 851968
    buffer_load_dwordx4 v15, s[16:19], s36 offen lds
L_p2:
    s_waitcnt vmcnt(0)
L_p2_own:
    s_barrier
    buffer_load_dwordx4 v[48:51], v29, s[28:31], s56 offen offset:0 sc1
    buffer_load_dword v76, v30, s[28:31], s58 offen offset:0 sc1
    buffer_load_dword v201, v201, s[28:31], 0 offen sc1
    ds_read_b64_tr_b16 v[84:85], v16 offset:0
    ds_read_b64_tr_b16 v[86:87], v16 offset:1024
    ds_read_b64_tr_b16 v[88:89], v17 offset:0
    ds_read_b64_tr_b16 v[90:91], v17 offset:1024
    ds_read_b64_tr_b16 v[92:93], v18 offset:0
    ds_read_b64_tr_b16 v[94:95], v18 offset:1024
    ds_read_b64_tr_b16 v[96:97], v19 offset:0
    ds_read_b64_tr_b16 v[98:99], v19 offset:1024
    buffer_load_dwordx4 v[52:55], v29, s[28:31], s56 offen offset:1024 sc1
    buffer_load_dword v77, v30, s[28:31], s58 offen offset:256 sc1
    ds_read_b64_tr_b16 v[100:101], v16 offset:4096
    ds_read_b64_tr_b16 v[102:103], v16 offset:5120
    ds_read_b64_tr_b16 v[104:105], v17 offset:4096
    ds_read_b64_tr_b16 v[106:107], v17 offset:5120
    ds_read_b64_tr_b16 v[108:109], v18 offset:4096
    ds_read_b64_tr_b16 v[110:111], v18 offset:5120
    ds_read_b64_tr_b16 v[112:113], v19 offset:4096
    ds_read_b64_tr_b16 v[114:115], v19 offset:5120
    buffer_load_dwordx4 v[56:59], v29, s[28:31], s56 offen offset:2048 sc1
    buffer_load_dword v78, v30, s[28:31], s58 offen offset:512 sc1
    buffer_load_dwordx4 v[60:63], v29, s[28:31], s56 offen offset:3072 sc1
    buffer_load_dword v79, v30, s[28:31], s58 offen offset:768 sc1
    s_waitcnt vmcnt(6) lgkmcnt(8)
    v_mfma_f32_16x16x32_bf16 v[32:35], v[48:51], v[84:87], 0
    buffer_load_dwordx4 v[64:67], v29, s[28:31], s57 offen offset:0 sc1
    ds_read_b64_tr_b16 v[116:117], v16 offset:8192
    ds_read_b64_tr_b16 v[118:119], v16 offset:9216
    v_add3_u32 v2, v48, v49, v50
    v_mfma_f32_16x16x32_bf16 v[36:39], v[48:51], v[88:91], 0
    buffer_load_dword v80, v30, s[28:31], s58 offen offset:1024 sc1
    ds_read_b64_tr_b16 v[120:121], v17 offset:8192
    ds_read_b64_tr_b16 v[122:123], v17 offset:9216
    v_lshl_add_u32 v2, v51, 1, v2
    v_mfma_f32_16x16x32_bf16 v[40:43], v[48:51], v[92:95], 0
    ds_read_b64_tr_b16 v[124:125], v18 offset:8192
    ds_read_b64_tr_b16 v[126:127], v18 offset:9216
    v_bitop3_b32 v28, v2, v76, v20 bitop3:0x96
    v_mfma_f32_16x16x32_bf16 v[44:47], v[48:51], v[96:99], 0
    ds_read_b64_tr_b16 v[128:129], v19 offset:8192
    ds_read_b64_tr_b16 v[130:131], v19 offset:9216
    s_waitcnt vmcnt(6) lgkmcnt(8)
    v_mfma_f32_16x16x32_bf16 v[32:35], v[52:55], v[100:103], v[32:35]
    buffer_load_dwordx4 v[68:71], v29, s[28:31], s57 offen offset:1024 sc1
    ds_read_b64_tr_b16 v[132:133], v16 offset:12288
    ds_read_b64_tr_b16 v[134:135], v16 offset:13312
    v_add3_u32 v2, v52, v53, v54
    v_mfma_f32_16x16x32_bf16 v[36:39], v[52:55], v[104:107], v[36:39]
    buffer_load_dword v81, v30, s[28:31], s58 offen offset:1280 sc1
    ds_read_b64_tr_b16 v[136:137], v17 offset:12288
    ds_read_b64_tr_b16 v[138:139], v17 offset:13312
    v_lshl_add_u32 v2, v55, 1, v2
    v_mfma_f32_16x16x32_bf16 v[40:43], v[52:55], v[108:111], v[40:43]
    ds_read_b64_tr_b16 v[140:141], v18 offset:12288
    ds_read_b64_tr_b16 v[142:143], v18 offset:13312
    v_bitop3_b32 v5, v2, v77, v20 bitop3:0x96
    v_mfma_f32_16x16x32_bf16 v[44:47], v[52:55], v[112:115], v[44:47]
    ds_read_b64_tr_b16 v[144:145], v19 offset:12288
    ds_read_b64_tr_b16 v[146:147], v19 offset:13312
    s_waitcnt vmcnt(6) lgkmcnt(8)
    v_mfma_f32_16x16x32_bf16 v[32:35], v[56:59], v[116:119], v[32:35]
    buffer_load_dwordx4 v[72:75], v29, s[28:31], s57 offen offset:2048 sc1
    ds_read_b64_tr_b16 v[148:149], v16 offset:16384
    ds_read_b64_tr_b16 v[150:151], v16 offset:17408
    v_add3_u32 v2, v56, v57, v58
    v_mfma_f32_16x16x32_bf16 v[36:39], v[56:59], v[120:123], v[36:39]
    buffer_load_dword v82, v30, s[28:31], s58 offen offset:1536 sc1
    ds_read_b64_tr_b16 v[152:153], v17 offset:16384
    ds_read_b64_tr_b16 v[154:155], v17 offset:17408
    v_lshl_add_u32 v2, v59, 1, v2
    v_mfma_f32_16x16x32_bf16 v[40:43], v[56:59], v[124:127], v[40:43]
    ds_read_b64_tr_b16 v[156:157], v18 offset:16384
    ds_read_b64_tr_b16 v[158:159], v18 offset:17408
    v_bitop3_b32 v2, v2, v78, v20 bitop3:0x96
    v_mfma_f32_16x16x32_bf16 v[44:47], v[56:59], v[128:131], v[44:47]
    ds_read_b64_tr_b16 v[160:161], v19 offset:16384
    ds_read_b64_tr_b16 v[162:163], v19 offset:17408
    v_or3_b32 v28, v28, v2, v5
    s_waitcnt vmcnt(6) lgkmcnt(8)
    v_mfma_f32_16x16x32_bf16 v[32:35], v[60:63], v[132:135], v[32:35]
    ds_read_b64_tr_b16 v[164:165], v16 offset:20480
    ds_read_b64_tr_b16 v[166:167], v16 offset:21504
    v_add3_u32 v2, v60, v61, v62
    v_mfma_f32_16x16x32_bf16 v[36:39], v[60:63], v[136:139], v[36:39]
    ds_read_b64_tr_b16 v[168:169], v17 offset:20480
    ds_read_b64_tr_b16 v[170:171], v17 offset:21504
    v_lshl_add_u32 v2, v63, 1, v2
    v_mfma_f32_16x16x32_bf16 v[40:43], v[60:63], v[140:143], v[40:43]
    ds_read_b64_tr_b16 v[172:173], v18 offset:20480
    ds_read_b64_tr_b16 v[174:175], v18 offset:21504
    v_bitop3_b32 v5, v2, v79, v20 bitop3:0x96
    v_mfma_f32_16x16x32_bf16 v[44:47], v[60:63], v[144:147], v[44:47]
    ds_read_b64_tr_b16 v[176:177], v19 offset:20480
    ds_read_b64_tr_b16 v[178:179], v19 offset:21504
    s_waitcnt vmcnt(4) lgkmcnt(8)
    v_mfma_f32_16x16x32_bf16 v[32:35], v[64:67], v[148:151], v[32:35]
    ds_read_b64_tr_b16 v[180:181], v16 offset:24576
    ds_read_b64_tr_b16 v[182:183], v16 offset:25600
    v_add3_u32 v2, v64, v65, v66
    v_mfma_f32_16x16x32_bf16 v[36:39], v[64:67], v[152:155], v[36:39]
    ds_read_b64_tr_b16 v[184:185], v17 offset:24576
    ds_read_b64_tr_b16 v[186:187], v17 offset:25600
    v_lshl_add_u32 v2, v67, 1, v2
    v_mfma_f32_16x16x32_bf16 v[40:43], v[64:67], v[156:159], v[40:43]
    ds_read_b64_tr_b16 v[188:189], v18 offset:24576
    ds_read_b64_tr_b16 v[190:191], v18 offset:25600
    v_bitop3_b32 v2, v2, v80, v20 bitop3:0x96
    v_mfma_f32_16x16x32_bf16 v[44:47], v[64:67], v[160:163], v[44:47]
    ds_read_b64_tr_b16 v[192:193], v19 offset:24576
    ds_read_b64_tr_b16 v[194:195], v19 offset:25600
    v_or3_b32 v28, v28, v2, v5
    s_waitcnt vmcnt(2) lgkmcnt(8)
    v_mfma_f32_16x16x32_bf16 v[32:35], v[68:71], v[164:167], v[32:35]
    v_add3_u32 v2, v68, v69, v70
    v_mfma_f32_16x16x32_bf16 v[36:39], v[68:71], v[168:171], v[36:39]
    v_lshl_add_u32 v2, v71, 1, v2
    v_mfma_f32_16x16x32_bf16 v[40:43], v[68:71], v[172:175], v[40:43]
    v_bitop3_b32 v5, v2, v81, v20 bitop3:0x96
    v_mfma_f32_16x16x32_bf16 v[44:47], v[68:71], v[176:179], v[44:47]
    v_cmp_ne_u32 vcc, v201, v202
    s_cbranch_vccnz L_pub
L_pub_done:
    s_waitcnt vmcnt(0) lgkmcnt(0)
    v_mfma_f32_16x16x32_bf16 v[40:43], v[72:75], v[188:191], v[40:43]
    v_add3_u32 v2, v72, v73, v74
    v_mfma_f32_16x16x32_bf16 v[44:47], v[72:75], v[192:195], v[44:47]
    v_lshl_add_u32 v2, v75, 1, v2
    v_mfma_f32_16x16x32_bf16 v[32:35], v[72:75], v[180:183], v[32:35]
    v_bitop3_b32 v2, v2, v82, v20 bitop3:0x96
    v_mfma_f32_16x16x32_bf16 v[36:39], v[72:75], v[184:187], v[36:39]
    v_or3_b32 v28, v28, v2, v5
    s_nop 1
    v_cmp_ne_u32 vcc, 0, v28
    s_cbranch_vccnz L_h_retry
L_h_ok:
    ds_write_b128 v23, v[40:43]
    ds_write_b128 v23, v[44:47] offset:1024
    s_mov_b32 s73, 262144
    s_waitcnt lgkmcnt(0)
    s_barrier
    ds_read_b128 v[48:51], v31
    ds_read_b128 v[52:55], v31 offset:1024
    s_waitcnt lgkmcnt(1)
    v_pk_add_f32 v[32:33], v[32:33], v[48:49]
    v_pk_add_f32 v[34:35], v[34:35], v[50:51]
    v_perm_b32 v56, v32, v20, s52
    v_perm_b32 v57, v33, v20, s53
    v_perm_b32 v58, v34, v20, s54
    v_perm_b32 v59, v35, v20, s55
    buffer_store_dwordx4 v[56:59], v26, s[28:31], s59 offen offset:0 sc1
    s_waitcnt lgkmcnt(0)
    v_pk_add_f32 v[36:37], v[36:37], v[52:53]
    v_pk_add_f32 v[38:39], v[38:39], v[54:55]
    v_perm_b32 v60, v36, v20, s52
    v_perm_b32 v61, v37, v20, s53
    v_perm_b32 v62, v38, v20, s54
    v_perm_b32 v63, v39, v20, s55
    buffer_store_dwordx4 v[60:63], v26, s[28:31], s59 offen offset:2048 sc1
    s_waitcnt vmcnt(0)
L_r:
    buffer_load_dwordx4 v[84:87], v21, s[28:31], s60 offen offset:0 sc1
    buffer_load_dwordx4 v[88:91], v21, s[28:31], s60 offen offset:1024 sc1
    s_waitcnt vmcnt(1)
    v_xor_b32 v84, s48, v84
    v_xor_b32 v85, s49, v85
    v_xor_b32 v86, s50, v86
    v_xor_b32 v87, s51, v87
    v_or3_b32 v28, v84, v85, v86
    s_waitcnt vmcnt(0)
    v_xor_b32 v88, s48, v88
    v_xor_b32 v89, s49, v89
    v_xor_b32 v90, s50, v90
    v_xor_b32 v91, s51, v91
    v_or3_b32 v28, v28, v87, v88
    v_or3_b32 v2, v89, v90, v91
    v_pk_add_f32 v[32:33], v[84:85], v[88:89]
    v_pk_add_f32 v[34:35], v[86:87], v[90:91]
    v_or_b32 v28, v28, v2
    v_and_b32 v28, 0xff, v28
    v_cmp_ne_u32 vcc, 0, v28
    s_cbranch_vccnz L_r_retry
    v_permlane32_swap_b32 v32, v34
    v_permlane32_swap_b32 v33, v35
    s_nop 0
    v_pk_add_f32 v[32:33], v[32:33], v[34:35]
    s_nop 1
    v_permlane16_swap_b32 v32, v33
    s_nop 1
    v_add_f32 v32, v32, v33
    v_cvt_pk_bf16_f32 v32, v32, v32
    buffer_store_short v32, v27, s[20:23], s61 offen
L_end:
    s_endpgm
L_stub:
    s_setpc_b64 s[68:69]
L_r_retry:
    s_sub_u32 s73, s73, 1
    s_cbranch_scc0 L_r
    s_endpgm
L_pub:
    s_add_u32 s64, s64, 4194304
    s_add_u32 s65, s65, 4194304
    buffer_store_dwordx4 v[196:199], v24, s[28:31], s64 offen sc1
    buffer_store_dword v200, v25, s[28:31], s65 offen sc1
    v_mov_b32 v201, v202
    s_waitcnt vmcnt(0)
    s_branch L_pub_done
L_h_retry:
    s_sub_u32 s73, s73, 1
    s_cbranch_scc1 L_end
    s_cmp_gt_u32 s73, 262120
    s_cbranch_scc1 L_h
    v_xor_b32 v29, 4194304, v29
    v_xor_b32 v30, 4194304, v30
L_h:
    buffer_load_dwordx4 v[48:51], v29, s[28:31], s56 offen offset:0 sc1
    buffer_load_dword v76, v30, s[28:31], s58 offen offset:0 sc1
    buffer_load_dwordx4 v[52:55], v29, s[28:31], s56 offen offset:1024 sc1
    buffer_load_dword v77, v30, s[28:31], s58 offen offset:256 sc1
    buffer_load_dwordx4 v[56:59], v29, s[28:31], s56 offen offset:2048 sc1
    buffer_load_dword v78, v30, s[28:31], s58 offen offset:512 sc1
    buffer_load_dwordx4 v[60:63], v29, s[28:31], s56 offen offset:3072 sc1
    buffer_load_dword v79, v30, s[28:31], s58 offen offset:768 sc1
    buffer_load_dwordx4 v[64:67], v29, s[28:31], s57 offen offset:0 sc1
    buffer_load_dword v80, v30, s[28:31], s58 offen offset:1024 sc1
    buffer_load_dwordx4 v[68:71], v29, s[28:31], s57 offen offset:1024 sc1
    buffer_load_dword v81, v30, s[28:31], s58 offen offset:1280 sc1
    buffer_load_dwordx4 v[72:75], v29, s[28:31], s57 offen offset:2048 sc1
    buffer_load_dword v82, v30, s[28:31], s58 offen offset:1536 sc1
    s_waitcnt vmcnt(12)
    v_mfma_f32_16x16x32_bf16 v[32:35], v[48:51], v[84:87], 0
    v_add3_u32 v2, v48, v49, v50
    v_mfma_f32_16x16x32_bf16 v[36:39], v[48:51], v[88:91], 0
    v_lshl_add_u32 v2, v51, 1, v2
    v_mfma_f32_16x16x32_bf16 v[40:43], v[48:51], v[92:95], 0
    v_bitop3_b32 v28, v2, v76, v20 bitop3:0x96
    v_mfma_f32_16x16x32_bf16 v[44:47], v[48:51], v[96:99], 0
    s_waitcnt vmcnt(10)
    v_mfma_f32_16x16x32_bf16 v[32:35], v[52:55], v[100:103], v[32:35]
    v_add3_u32 v2, v52, v53, v54
    v_mfma_f32_16x16x32_bf16 v[36:39], v[52:55], v[104:107], v[36:39]
    v_lshl_add_u32 v2, v55, 1, v2
    v_mfma_f32_16x16x32_bf16 v[40:43], v[52:55], v[108:111], v[40:43]
    v_bitop3_b32 v5, v2, v77, v20 bitop3:0x96
    v_mfma_f32_16x16x32_bf16 v[44:47], v[52:55], v[112:115], v[44:47]
    s_waitcnt vmcnt(8)
    v_mfma_f32_16x16x32_bf16 v[32:35], v[56:59], v[116:119], v[32:35]
    v_add3_u32 v2, v56, v57, v58
    v_mfma_f32_16x16x32_bf16 v[36:39], v[56:59], v[120:123], v[36:39]
    v_lshl_add_u32 v2, v59, 1, v2
    v_mfma_f32_16x16x32_bf16 v[40:43], v[56:59], v[124:127], v[40:43]
    v_bitop3_b32 v2, v2, v78, v20 bitop3:0x96
    v_mfma_f32_16x16x32_bf16 v[44:47], v[56:59], v[128:131], v[44:47]
    v_or3_b32 v28, v28, v2, v5
    s_waitcnt vmcnt(6)
    v_mfma_f32_16x16x32_bf16 v[32:35], v[60:63], v[132:135], v[32:35]
    v_add3_u32 v2, v60, v61, v62
    v_mfma_f32_16x16x32_bf16 v[36:39], v[60:63], v[136:139], v[36:39]
    v_lshl_add_u32 v2, v63, 1, v2
    v_mfma_f32_16x16x32_bf16 v[40:43], v[60:63], v[140:143], v[40:43]
    v_bitop3_b32 v5, v2, v79, v20 bitop3:0x96
    v_mfma_f32_16x16x32_bf16 v[44:47], v[60:63], v[144:147], v[44:47]
    s_waitcnt vmcnt(4)
    v_mfma_f32_16x16x32_bf16 v[32:35], v[64:67], v[148:151], v[32:35]
    v_add3_u32 v2, v64, v65, v66
    v_mfma_f32_16x16x32_bf16 v[36:39], v[64:67], v[152:155], v[36:39]
    v_lshl_add_u32 v2, v67, 1, v2
    v_mfma_f32_16x16x32_bf16 v[40:43], v[64:67], v[156:159], v[40:43]
    v_bitop3_b32 v2, v2, v80, v20 bitop3:0x96
    v_mfma_f32_16x16x32_bf16 v[44:47], v[64:67], v[160:163], v[44:47]
    v_or3_b32 v28, v28, v2, v5
    s_waitcnt vmcnt(2)
    v_mfma_f32_16x16x32_bf16 v[32:35], v[68:71], v[164:167], v[32:35]
    v_add3_u32 v2, v68, v69, v70
    v_mfma_f32_16x16x32_bf16 v[36:39], v[68:71], v[168:171], v[36:39]
    v_lshl_add_u32 v2, v71, 1, v2
    v_mfma_f32_16x16x32_bf16 v[40:43], v[68:71], v[172:175], v[40:43]
    v_bitop3_b32 v5, v2, v81, v20 bitop3:0x96
    v_mfma_f32_16x16x32_bf16 v[44:47], v[68:71], v[176:179], v[44:47]
    s_waitcnt vmcnt(0)
    v_mfma_f32_16x16x32_bf16 v[40:43], v[72:75], v[188:191], v[40:43]
    v_add3_u32 v2, v72, v73, v74
    v_mfma_f32_16x16x32_bf16 v[44:47], v[72:75], v[192:195], v[44:47]
    v_lshl_add_u32 v2, v75, 1, v2
    v_mfma_f32_16x16x32_bf16 v[32:35], v[72:75], v[180:183], v[32:35]
    v_bitop3_b32 v2, v2, v82, v20 bitop3:0x96
    v_mfma_f32_16x16x32_bf16 v[36:39], v[72:75], v[184:187], v[36:39]
    v_or3_b32 v28, v28, v2, v5
    s_nop 1
    v_cmp_ne_u32 vcc, 0, v28
    s_cbranch_vccnz L_h_retry
    s_branch L_h_ok
L_pf_other:
    s_waitcnt vmcnt(0)
L_pf_rest:
    s_load_dwordx2 s[16:17], s[0:1], 24
    s_load_dwordx2 s[20:21], s[0:1], 32
    s_load_dwordx2 s[24:25], s[0:1], 40
    s_mov_b32 s18, s10
    s_mov_b32 s19, s7
    s_mov_b32 s22, s7
    s_mov_b32 s23, s7
    s_movk_i32 s26, 256
    s_mov_b32 s27, s7
    v_and_b32 v5, 6, v3
    v_xor_b32 v5, v5, v4
    v_lshlrev_b32 v5, 4, v5
    v_lshl_add_u32 v15, v3, 11, v5
    s_mul_i32 s42, s32, 917504
    s_and_b32 s36, s33, 15
    s_lshl_b32 s36, s36, 7
    s_add_u32 s42, s42, s36
    s_lshl_b32 s37, s34, 14
    s_add_u32 s42, s42, s37
    s_lshr_b32 s38, s33, 4
    s_lshl_b32 s61, s38, 16
    s_add_u32 s61, s61, s36
    s_lshl_b32 s36, s32, 13
    s_add_u32 s61, s61, s36
    s_lshl_b32 s36, s34, 5
    s_add_u32 s61, s61, s36
    s_lshr_b32 s36, s34, 1
    s_lshl_b32 s37, s32, 1
    s_add_u32 s37, s37, s38
    s_lshl_b32 s37, s37, 1
    s_and_b32 s38, s34, 1
    s_add_u32 s37, s37, s38
    s_lshl_b32 s37, s37, 1
    s_add_u32 s37, s37, s36
    s_mul_i32 s37, s37, 7
    s_lshl_b32 s58, s37, 8
    s_add_u32 s58, s58, 524288
    s_lshl_b32 s56, s37, 10
    s_add_u32 s56, s56, 65536
    s_add_u32 s57, s56, s66
    s_lshl_b32 s60, s33, 16
    s_add_u32 s60, s60, 1048576
    s_lshl_b32 s38, s38, 15
    s_add_u32 s59, s60, s38
    s_lshl_b32 s38, s36, 12
    s_add_u32 s59, s59, s38
    s_lshl_b32 s38, s32, 8
    s_add_u32 s59, s59, s38
    s_lshl_b32 s38, s32, 13
    s_add_u32 s60, s60, s38
    s_lshl_b32 s38, s34, 11
    s_add_u32 s60, s60, s38
    s_mov_b32 s52, 0x07060500
    s_add_u32 s53, s52, 1
    s_add_u32 s54, s52, 2
    s_add_u32 s55, s52, 3
    v_lshlrev_b32 v21, 4, v1
    v_lshlrev_b32 v30, 2, v1
    v_mov_b32 v29, v21
    s_add_u32 s38, s38, 57344
    v_add_u32 v23, s38, v21
    v_xor_b32 v31, s66, v23
    v_lshrrev_b32 v2, 5, v1
    v_lshlrev_b32 v2, 11, v2
    v_bfe_u32 v5, v1, 2, 3
    v_lshl_add_u32 v2, v5, 7, v2
    v_and_b32 v5, 3, v1
    v_lshl_add_u32 v2, v5, 3, v2
    s_and_b32 s37, s34, 2
    v_and_b32 v5, 3, v3
    v_xor_b32 v5, s37, v5
    v_lshl_add_u32 v2, v5, 5, v2
    s_mul_i32 s36, s36, 28672
    v_add_u32 v16, s36, v2
    v_xor_b32 v17, 32, v16
    v_xor_b32 v18, 64, v16
    v_xor_b32 v19, 96, v16
    v_lshrrev_b32 v2, 4, v1
    v_and_b32 v5, 15, v1
    v_lshlrev_b32 v26, 13, v2
    v_lshl_add_u32 v26, v5, 4, v26
    v_lshlrev_b32 v27, 11, v2
    v_lshl_add_u32 v27, v5, 1, v27
    s_mov_b32 s73, 262144
    s_lshl_b32 s70, s32, 7
    s_add_u32 s70, s70, 4096
    v_and_b32 v201, 31, v1
    v_lshl_add_u32 v201, v201, 2, s70
    s_lshl_b32 s36, s33, 2
    s_add_u32 s70, s70, s36
    s_add_u32 s43, s42, 458752
    s_add_u32 s45, s35, 28672
    s_cmp_lt_u32 s33, 16
    s_cselect_b32 s36, s43, s42
    s_cselect_b32 s43, s42, s43
    s_mov_b32 s42, s36
    s_cselect_b32 s44, s45, s35
    s_cselect_b32 s45, s35, s45
    v_mov_b32 v24, 0x7ffffff0
    v_mov_b32 v25, v24
    s_mov_b32 s64, 0
    s_mov_b32 s65, 0
    v_mov_b32 v196, 0
    v_mov_b32 v197, 0
    v_mov_b32 v198, 0
    v_mov_b32 v199, 0
    v_mov_b32 v200, 0
    s_waitcnt vmcnt(18) lgkmcnt(0)
    buffer_load_dword v20, off, s[24:27], 0 sc1
    s_cmp_lg_u32 s34, 1
    s_cbranch_scc1 L_pf_notouch
    s_mul_i32 s36, s32, 57344
    s_lshl_b32 s37, s41, 13
    s_add_u32 s36, s36, s37
    s_add_u32 s36, s36, 65536
    s_mul_i32 s38, s32, 14336
    s_add_u32 s38, s38, s37
    s_add_u32 s38, s38, 466944
    s_cmp_ge_u32 s41, 7
    s_cselect_b32 s36, s38, s36
    s_cmp_ge_u32 s41, 9
    s_cbranch_scc1 L_pf_notouch
    v_lshlrev_b32 v5, 7, v1
    buffer_load_dword v22, v5, s[28:31], s36 offen
L_pf_notouch:
    s_cmp_lg_u32 s34, 0
    s_cbranch_scc1 L_pf_noc3
    s_mul_i32 s36, s41, 25
    s_mul_i32 s37, s32, 448
    s_add_u32 s37, s37, s36
    s_lshl_b32 s37, s37, 11
    v_min_u32 v5, 49, v1
    v_lshlrev_b32 v5, 10, v5
    buffer_load_dword v22, v5, s[16:19], s37 offen offset:384
L_pf_noc3:
    s_lshl_b32 s38, s2, 2
    s_add_u32 s38, s38, s34
    buffer_load_dword v22, v201, s[28:31], 0 offen
    s_getreg_b32 s68, hwreg(HW_REG_XCC_ID, 0, 4)
    s_lshl_b32 s68, s68, 24
    s_add_u32 s68, s68, 0x5a
    v_add_u32 v202, s68, v203
    s_mov_b64 exec, 1
    buffer_store_dword v202, off, s[28:31], s70
    s_mov_b64 exec, -1
    s_barrier
    s_mov_b32 m0, s44
    s_add_u32 s36, s42, 0
    buffer_load_dwordx4 v15, s[16:19], s36 offen lds
    s_add_u32 m0, m0, s66
    s_add_u32 s36, s42, 65536
    buffer_load_dwordx4 v15, s[16:19], s36 offen lds
    s_add_u32 m0, m0, s66
    s_add_u32 s36, s42, 131072
    buffer_load_dwordx4 v15, s[16:19], s36 offen lds
    s_add_u32 m0, m0, s66
    s_add_u32 s36, s42, 196608
    buffer_load_dwordx4 v15, s[16:19], s36 offen lds
    s_add_u32 m0, m0, s66
    s_add_u32 s36, s42, 262144
    buffer_load_dwordx4 v15, s[16:19], s36 offen lds
    s_add_u32 m0, m0, s66
    s_add_u32 s36, s42, 327680
    buffer_load_dwordx4 v15, s[16:19], s36 offen lds
    s_add_u32 m0, m0, s66
    s_add_u32 s36, s42, 393216
    buffer_load_dwordx4 v15, s[16:19], s36 offen lds
    s_mov_b32 m0, s45
    s_add_u32 s36, s43, 0
    buffer_load_dwordx4 v15, s[16:19], s36 offen lds
    s_add_u32 m0, m0, s66
    s_add_u32 s36, s43, 65536
    buffer_load_dwordx4 v15, s[16:19], s36 offen lds
    s_add_u32 m0, m0, s66
    s_add_u32 s36, s43, 131072
    buffer_load_dwordx4 v15, s[16:19], s36 offen lds
    s_add_u32 m0, m0, s66
    s_add_u32 s36, s43, 196608
    buffer_load_dwordx4 v15, s[16:19], s36 offen lds
    s_add_u32 m0, m0, s66
    s_add_u32 s36, s43, 262144
    buffer_load_dwordx4 v15, s[16:19], s36 offen lds
    s_add_u32 m0, m0, s66
    s_add_u32 s36, s43, 327680
    buffer_load_dwordx4 v15, s[16:19], s36 offen lds
    s_add_u32 m0, m0, s66
    s_add_u32 s36, s43, 393216
    buffer_load_dwordx4 v15, s[16:19], s36 offen lds
    s_call_b64 s[68:69], L_stub
    s_waitcnt vmcnt(14)
    v_readfirstlane_b32 s74, v203
    v_readfirstlane_b32 s75, v20
    s_nop 0
    s_add_u32 s74, s74, 0x01010101
    s_cmp_eq_u32 s74, 0
    s_cselect_b32 s74, 0x02020202, s74
    s_cmp_eq_u32 s75, 0
    s_cselect_b32 s46, s74, s75
    v_mov_b32 v20, s46
    s_bfe_u32 s48, s46, 524288
    s_bfe_u32 s49, s46, 524296
    s_bfe_u32 s50, s46, 524304
    s_bfe_u32 s51, s46, 524312
    s_cmp_eq_u32 s74, s46
    s_cbranch_scc1 L_mk_pf
    s_mov_b64 exec, 1
    buffer_store_dword v20, off, s[28:31], s70
    s_mov_b64 exec, -1
L_mk_pf:
    s_cmp_lg_u32 s38, 629
    s_cbranch_scc1 L_p2
    s_mov_b64 exec, 1
    buffer_store_dword v20, off, s[24:27], 0 sc1
    s_mov_b64 exec, -1
    s_waitcnt vmcnt(0)
    s_mov_b64 exec, 1
    buffer_store_dword v20, off, s[28:31], s71
    s_mov_b64 exec, -1
L_last:
    s_branch L_p2_own
.section .rodata,"a"
.p2align 6
.amdhsa_kernel standalone__swiglu_ffn__sampling_kernel
  .amdhsa_next_free_vgpr 208
  .amdhsa_next_free_sgpr 80
  .amdhsa_accum_offset 208
  .amdhsa_group_segment_fixed_size 0
  .amdhsa_kernarg_size 56
  .amdhsa_user_sgpr_count 2
  .amdhsa_user_sgpr_kernarg_segment_ptr 1
  .amdhsa_system_sgpr_workgroup_id_x 1
  .amdhsa_float_denorm_mode_32 3
.end_amdhsa_kernel
```
